```python
import torch

def _softmax(x, axis=-1):
    return torch.softmax(x, dim=axis)
def _gelu(x):
    return torch.nn.functional.gelu(x, approximate="tanh")
def _silu(x):
    return torch.nn.functional.silu(x)
def _sigmoid(x):
    return torch.sigmoid(x)
def _layernorm(x, axis=-1, eps=1e-5):
    m = x.mean(dim=axis, keepdim=True)
    v = x.var(dim=axis, keepdim=True, unbiased=False)
    return (x - m) / torch.sqrt(v + eps)
def _scatter_add(tgt, idx, src, axis=0):
    return tgt.clone().index_add_(axis, idx, src)
def _segment_sum(src, seg, n):
    out = torch.zeros((n,) + src.shape[1:], dtype=src.dtype)
    return out.index_add_(0, seg, src)
def _pad(x, pw):
    flat = tuple(v for pair in reversed(pw) for v in pair)
    return torch.nn.functional.pad(x, flat)

kernel_name = 'standalone__paged_block_table_kv_radixattention__decode'

def setup_inputs():

    _w = (lambda a: (lambda t: t.to(torch.bfloat16) if t.is_floating_point() else t)(torch.as_tensor(a)))
    B, H, Hkv, Dh = 1, 16, 8, 256
    Lk = 8192
    bs = 16
    nb = max(2, Lk // bs)
    P = max(1, nb // 2)
    n_phys = P + B * (nb - P)
    shared = torch.arange(P, dtype=torch.int64)
    priv = P + torch.arange(B * (nb - P), dtype=torch.int64).reshape(B, nb - P)
    bt = torch.cat([torch.tile(shared[None, :], (B, 1)), priv], dim=1)
    ctx = nb * bs - (torch.arange(1, B + 1, dtype=torch.int64) * 2654435761) % max(1, (nb * bs - P * bs) // 2)
    return {
        "q": _w((lambda *s: torch.randn(*s, dtype=torch.bfloat16) * 0.8)(B, H, Dh)),
        "k_cache": _w((lambda *s: torch.randn(*s, dtype=torch.bfloat16) * 0.8)(n_phys, bs, Hkv, Dh)),
        "v_cache": _w((lambda *s: torch.randn(*s, dtype=torch.bfloat16) * 0.05)(n_phys, bs, Hkv, Dh)),
        "block_table": _w(bt.to(torch.int64)),
        "ctx_lens": _w(torch.as_tensor(ctx).to(torch.int64)),
    }

def reference(q, k_cache, v_cache, block_table, ctx_lens):
    B, H, Dh = q.shape
    n_phys, bs, Hkv, _ = k_cache.shape
    nb = block_table.shape[1]
    Lk = nb * bs
    rep = H // Hkv
    k = k_cache[block_table].reshape(B, Lk, Hkv, Dh)
    v = v_cache[block_table].reshape(B, Lk, Hkv, Dh)
    k = (lambda x, n, axis: torch.repeat_interleave(x, n, dim=axis))(k, rep, axis=2)
    v = (lambda x, n, axis: torch.repeat_interleave(x, n, dim=axis))(v, rep, axis=2)
    scores = torch.einsum("bhd,bkhd->bhk", q, k) * (Dh ** -0.5)
    pos = torch.arange(Lk)
    valid = pos[None, :] < ctx_lens[:, None]
    scores = torch.where(valid[:, None, :], scores, -1e9)
    p = _softmax(scores, axis=-1)
    return torch.einsum("bhk,bkhd->bhd", p, v)
```

```asm
; @launch grid=(256,1,1) block=(320,1,1) lds=7168
.amdgcn_target "amdgcn-amd-amdhsa--gfx950"
.text
.globl standalone__paged_block_table_kv_radixattention__decode_kernel
.p2align 12
.p2align 8
.type standalone__paged_block_table_kv_radixattention__decode_kernel,@function
standalone__paged_block_table_kv_radixattention__decode_kernel:
    s_load_dwordx2 s[20:21], s[0:1], 8
    s_cmp_ge_u32 s2, 256
    s_cbranch_scc1 Lm_end
    v_readfirstlane_b32 s3, v0
    s_lshr_b32 s28, s2, 3
    s_and_b32 s29, s2, 7
    s_lshl_b32 s39, s29, 10
    s_lshr_b32 s3, s3, 6
    s_cmp_eq_u32 s3, 4
    s_cbranch_scc1 Lh_table
    v_bfe_u32 v6, v0, 4, 2
    v_and_b32 v3, 7, v0
    v_lshlrev_b32 v1, 12, v3
    v_bfe_u32 v3, v0, 3, 1
    v_lshl_add_u32 v1, v3, 6, v1
    v_lshl_add_u32 v1, v6, 4, v1
    s_lshl_b32 s40, s3, 5
    s_add_u32 s40, s40, s28
    s_lshl_b32 s40, s40, 7
    s_add_u32 s40, s40, s29
    s_lshl_b32 s40, s40, 9
    s_mov_b32 s22, 0x2000000
    s_mov_b32 s23, 0x20000
    s_mov_b32 s27, 0x20000
    v_and_b32 v5, 15, v0
    v_lshlrev_b32 v3, 9, v3
    v_and_b32 v4, 1, v0
    v_lshl_add_u32 v3, v4, 6, v3
    v_lshl_add_u32 v3, v6, 4, v3
    v_add_u32 v3, s39, v3
    v_lshlrev_b32 v2, 14, v6
    v_lshl_add_u32 v2, v5, 4, v2
    s_cmp_eq_u32 s3, 0
    s_cselect_b32 s35, 0x100, 0
    v_xor_b32 v2, s35, v2
    v_xor_b32 v210, 0x100, v2
    v_lshlrev_b32 v4, 4, v4
    v_mov_b32 v10, 0xffff
    v_lshlrev_b32 v4, v4, v10
    v_bfe_u32 v10, v0, 1, 2
    v_cmp_eq_u32 s[52:53], 0, v10
    v_cmp_eq_u32 s[54:55], 1, v10
    v_cmp_eq_u32 s[56:57], 2, v10
    v_cmp_eq_u32 s[58:59], 3, v10
    v_mov_b32 v8, 0xff800000
    v_mov_b32 v10, 0xff61b1e6
    v_cndmask_b32 v12, 0, v4, s[52:53]
    v_cndmask_b32 v13, 0, v4, s[54:55]
    v_cndmask_b32 v14, 0, v4, s[56:57]
    v_cndmask_b32 v15, 0, v4, s[58:59]
    v_lshlrev_b32 v9, 2, v6
    s_waitcnt lgkmcnt(0)
    buffer_load_dwordx4 v[80:83], v1, s[20:23], s40 offen offset:0 nt
    buffer_load_dwordx4 v[84:87], v1, s[20:23], s40 offen offset:128 nt
    buffer_load_dwordx4 v[88:91], v1, s[20:23], s40 offen offset:256 nt
    buffer_load_dwordx4 v[92:95], v1, s[20:23], s40 offen offset:384 nt
    s_add_u32 s48, s40, 0x8000
    buffer_load_dwordx4 v[96:99], v1, s[20:23], s48 offen offset:0 nt
    buffer_load_dwordx4 v[100:103], v1, s[20:23], s48 offen offset:128 nt
    buffer_load_dwordx4 v[104:107], v1, s[20:23], s48 offen offset:256 nt
    buffer_load_dwordx4 v[108:111], v1, s[20:23], s48 offen offset:384 nt
    s_load_dwordx2 s[24:25], s[0:1], 16
    s_load_dwordx2 s[4:5], s[0:1], 0
    s_load_dwordx2 s[10:11], s[0:1], 32
    s_load_dwordx2 s[16:17], s[0:1], 56
    s_waitcnt lgkmcnt(0)
    s_load_dword s38, s[16:17], s39
    s_load_dword s33, s[10:11], 0
    global_load_dwordx4 v[64:67], v3, s[4:5] offset:0
    global_load_dwordx4 v[68:71], v3, s[4:5] offset:128
    global_load_dwordx4 v[72:75], v3, s[4:5] offset:256
    global_load_dwordx4 v[76:79], v3, s[4:5] offset:384
    s_add_u32 s48, s40, 0x800000
    buffer_load_dwordx4 v[112:115], v1, s[20:23], s48 offen offset:0 nt
    buffer_load_dwordx4 v[116:119], v1, s[20:23], s48 offen offset:128 nt
    buffer_load_dwordx4 v[120:123], v1, s[20:23], s48 offen offset:256 nt
    buffer_load_dwordx4 v[124:127], v1, s[20:23], s48 offen offset:384 nt
    s_add_u32 s48, s40, 0x808000
    s_waitcnt vmcnt(9)
    buffer_load_dwordx4 v[128:131], v1, s[20:23], s48 offen offset:0 nt
    buffer_load_dwordx4 v[132:135], v1, s[20:23], s48 offen offset:128 nt
    buffer_load_dwordx4 v[136:139], v1, s[20:23], s48 offen offset:256 nt
    buffer_load_dwordx4 v[140:143], v1, s[20:23], s48 offen offset:384 nt
    s_branch Lm_b
Lh_table:
    s_setprio 3
    s_load_dwordx4 s[8:11], s[0:1], 24
    s_load_dwordx2 s[12:13], s[0:1], 40
    s_load_dwordx2 s[16:17], s[0:1], 56
    v_and_b32 v0, 63, v0
    v_lshlrev_b32 v1, 4, v0
    v_lshlrev_b32 v2, 2, v0
    v_mov_b32 v9, 0
    s_waitcnt lgkmcnt(0)
    global_load_dwordx4 v[48:51], v1, s[8:9]
    global_load_dwordx4 v[52:55], v1, s[8:9] offset:1024
    s_load_dword s33, s[10:11], 0
    s_load_dword s38, s[16:17], s39
    ds_write_b32 v2, v9 offset:128
    v_and_b32 v6, 3, v0
    v_bfe_u32 v11, v0, 2, 2
    v_lshl_add_u32 v11, v6, 2, v11
    v_and_or_b32 v11, v0, 16, v11
    v_lshlrev_b32 v11, 2, v11
    s_and_b32 s34, s28, 1
    s_sub_u32 s34, s34, 480
    v_mov_b32 v10, 0x2000000
    s_movk_i32 s37, 0xfe00
    s_waitcnt lgkmcnt(0)
    s_cmp_lt_i32 s33, 1
    s_cselect_b32 s33, 0x2000, s33
    s_min_u32 s33, s33, 0x2000
    s_and_b32 s36, s33, 15
    s_lshl_b32 s36, s36, 16
    s_lshr_b32 s33, s33, 4
    v_sub_u32 v12, s33, v2
    v_mov_b32 v13, s36
    v_cmp_eq_u32 vcc, 0, v12
    v_cmp_lt_i32 s[52:53], 0, v12
    s_nop 0
    v_cndmask_b32 v32, 0, v13, vcc
    v_cndmask_b32 v32, v32, 1, s[52:53]
    v_cmp_eq_u32 vcc, 1, v12
    v_cmp_lt_i32 s[52:53], 1, v12
    s_nop 0
    v_cndmask_b32 v33, 0, v13, vcc
    v_cndmask_b32 v33, v33, 1, s[52:53]
    v_cmp_eq_u32 vcc, 2, v12
    v_cmp_lt_i32 s[52:53], 2, v12
    s_nop 0
    v_cndmask_b32 v34, 0, v13, vcc
    v_cndmask_b32 v34, v34, 1, s[52:53]
    v_cmp_eq_u32 vcc, 3, v12
    v_cmp_lt_i32 s[52:53], 3, v12
    s_nop 0
    v_cndmask_b32 v35, 0, v13, vcc
    v_cndmask_b32 v35, v35, 1, s[52:53]
    v_subrev_u32 v12, 0x100, v12
    v_cmp_eq_u32 vcc, 0, v12
    v_cmp_lt_i32 s[52:53], 0, v12
    s_nop 0
    v_cndmask_b32 v36, 0, v13, vcc
    v_cndmask_b32 v36, v36, 1, s[52:53]
    v_cmp_eq_u32 vcc, 1, v12
    v_cmp_lt_i32 s[52:53], 1, v12
    s_nop 0
    v_cndmask_b32 v37, 0, v13, vcc
    v_cndmask_b32 v37, v37, 1, s[52:53]
    v_cmp_eq_u32 vcc, 2, v12
    v_cmp_lt_i32 s[52:53], 2, v12
    s_nop 0
    v_cndmask_b32 v38, 0, v13, vcc
    v_cndmask_b32 v38, v38, 1, s[52:53]
    v_cmp_eq_u32 vcc, 3, v12
    v_cmp_lt_i32 s[52:53], 3, v12
    s_nop 0
    v_cndmask_b32 v39, 0, v13, vcc
    v_cndmask_b32 v39, v39, 1, s[52:53]
    s_waitcnt vmcnt(1)
    v_lshl_add_u32 v14, v48, 1, s34
    v_max_i32 v14, v14, v48
    v_lshrrev_b32 v15, 3, v14
    v_and_b32 v14, 31, v14
    v_and_or_b32 v14, v48, s37, v14
    v_and_b32 v15, 0x7c, v15
    v_cmp_eq_u32 vcc, s28, v14
    s_mov_b64 exec, vcc
    ds_add_u32 v15, v32 offset:128
    s_mov_b64 exec, -1
    v_lshl_add_u32 v14, v49, 1, s34
    v_max_i32 v14, v14, v49
    v_lshrrev_b32 v15, 3, v14
    v_and_b32 v14, 31, v14
    v_and_or_b32 v14, v49, s37, v14
    v_and_b32 v15, 0x7c, v15
    v_cmp_eq_u32 vcc, s28, v14
    s_mov_b64 exec, vcc
    ds_add_u32 v15, v33 offset:128
    s_mov_b64 exec, -1
    v_lshl_add_u32 v14, v50, 1, s34
    v_max_i32 v14, v14, v50
    v_lshrrev_b32 v15, 3, v14
    v_and_b32 v14, 31, v14
    v_and_or_b32 v14, v50, s37, v14
    v_and_b32 v15, 0x7c, v15
    v_cmp_eq_u32 vcc, s28, v14
    s_mov_b64 exec, vcc
    ds_add_u32 v15, v34 offset:128
    s_mov_b64 exec, -1
    v_lshl_add_u32 v14, v51, 1, s34
    v_max_i32 v14, v14, v51
    v_lshrrev_b32 v15, 3, v14
    v_and_b32 v14, 31, v14
    v_and_or_b32 v14, v51, s37, v14
    v_and_b32 v15, 0x7c, v15
    v_cmp_eq_u32 vcc, s28, v14
    s_mov_b64 exec, vcc
    ds_add_u32 v15, v35 offset:128
    s_mov_b64 exec, -1
    s_waitcnt vmcnt(0)
    v_lshl_add_u32 v14, v52, 1, s34
    v_max_i32 v14, v14, v52
    v_lshrrev_b32 v15, 3, v14
    v_and_b32 v14, 31, v14
    v_and_or_b32 v14, v52, s37, v14
    v_and_b32 v15, 0x7c, v15
    v_cmp_eq_u32 vcc, s28, v14
    s_mov_b64 exec, vcc
    ds_add_u32 v15, v36 offset:128
    s_mov_b64 exec, -1
    v_lshl_add_u32 v14, v53, 1, s34
    v_max_i32 v14, v14, v53
    v_lshrrev_b32 v15, 3, v14
    v_and_b32 v14, 31, v14
    v_and_or_b32 v14, v53, s37, v14
    v_and_b32 v15, 0x7c, v15
    v_cmp_eq_u32 vcc, s28, v14
    s_mov_b64 exec, vcc
    ds_add_u32 v15, v37 offset:128
    s_mov_b64 exec, -1
    v_lshl_add_u32 v14, v54, 1, s34
    v_max_i32 v14, v14, v54
    v_lshrrev_b32 v15, 3, v14
    v_and_b32 v14, 31, v14
    v_and_or_b32 v14, v54, s37, v14
    v_and_b32 v15, 0x7c, v15
    v_cmp_eq_u32 vcc, s28, v14
    s_mov_b64 exec, vcc
    ds_add_u32 v15, v38 offset:128
    s_mov_b64 exec, -1
    v_lshl_add_u32 v14, v55, 1, s34
    v_max_i32 v14, v14, v55
    v_lshrrev_b32 v15, 3, v14
    v_and_b32 v14, 31, v14
    v_and_or_b32 v14, v55, s37, v14
    v_and_b32 v15, 0x7c, v15
    v_cmp_eq_u32 vcc, s28, v14
    s_mov_b64 exec, vcc
    ds_add_u32 v15, v39 offset:128
    s_mov_b64 exec, -1
    ds_read_b32 v12, v11 offset:128
    s_waitcnt lgkmcnt(0)
    v_and_b32 v17, 0xffff, v12
    v_cmp_ne_u32 vcc, 0, v12
    v_cvt_f32_u32 v17, v17
    v_lshrrev_b32 v18, 16, v12
    v_add_f32 v16, 1.0, v17
    v_log_f32 v17, v17
    v_log_f32 v16, v16
    v_cndmask_b32 v19, 0, v10, vcc
    s_mov_b64 exec, 0x1ffff
    ds_write_b128 v1, v[16:19] offset:256
    s_add_u32 s41, s38, 0x01010101
    s_xor_b32 s38, s41, 0x734f92d6
    s_getreg_b32 s50, hwreg(HW_REG_XCC_ID, 0, 4)
    s_lshl_b32 s50, s50, 24
    s_and_b32 s35, s38, 0xffffff
    s_or_b32 s50, s50, s35
    s_lshl_b32 s35, s28, 2
    s_add_u32 s35, s35, s39
    v_mov_b32 v10, s35
    v_mov_b32 v11, s50
    s_mov_b64 exec, 1
    global_store_dword v10, v11, s[16:17] offset:128
    s_mov_b64 exec, -1
    s_waitcnt lgkmcnt(0)
    s_barrier
    s_branch Lh_merge
Lm_b:
    s_lshl_b32 s35, s3, 6
    v_mov_b32 v4, s35
    s_lshr_b32 s34, s28, 1
    s_add_u32 s34, s34, 480
    s_lshl_b32 s34, s34, 1
    s_and_b32 s36, s28, 1
    s_add_u32 s34, s34, s36
    s_lshl_b32 s34, s34, 6
    s_add_u32 s34, s34, s29
    s_lshl_b32 s34, s34, 9
    s_add_u32 s30, s40, 0x1800000
    s_lshl_b32 s36, s36, 3
    s_cmp_eq_u32 s3, 3
    s_cselect_b32 s30, s34, s30
    s_cselect_b32 s31, 32, 1
    s_cselect_b32 s34, 16, 0
    s_cselect_b32 s35, 0, 8
    s_cselect_b32 s36, s36, 0
    s_lshl_b32 s31, s31, 15
    v_lshrrev_b32 v16, 1, v6
    v_mad_u32_u24 v3, v16, s34, v4
    v_and_b32 v208, 4, v9
    v_mad_u32_u24 v208, v16, s35, v208
    v_add_u32 v208, s36, v208
    v_and_b32 v209, 0x7fff, v2
    v_mad_u32_u24 v209, v16, s31, v209
    s_barrier
    ds_read_b128 v[40:43], v4 offset:256
    ds_read_b128 v[44:47], v4 offset:272
    ds_read_b128 v[48:51], v4 offset:288
    ds_read_b128 v[52:55], v3 offset:304
    v_or_b32 v16, 2.0, v209
    s_waitcnt lgkmcnt(0)
    v_cmp_eq_u32 vcc, 0, v55
    s_add_u32 s38, s38, 0x01010101
    s_xor_b32 s38, s38, 0x734f92d6
    s_cmp_lt_i32 s33, 1
    s_cselect_b32 s37, 0, 0x3db8aa3b
    v_readfirstlane_b32 s44, v43
    v_readfirstlane_b32 s45, v47
    v_readfirstlane_b32 s46, v51
    v_readfirstlane_b32 s47, v55
    v_readlane_b32 s32, v55, 32
    v_cndmask_b32 v209, v209, v16, vcc
    v_mov_b32 v7, s37
    v_xor_b32 v211, 0x100, v209
    s_mov_b32 s22, s46
    s_add_u32 s48, s40, 0x1000000
    s_waitcnt vmcnt(9)
    buffer_load_dwordx4 v[144:147], v1, s[20:23], s48 offen offset:0 nt
    buffer_load_dwordx4 v[148:151], v1, s[20:23], s48 offen offset:128 nt
    buffer_load_dwordx4 v[152:155], v1, s[20:23], s48 offen offset:256 nt
    buffer_load_dwordx4 v[156:159], v1, s[20:23], s48 offen offset:384 nt
    s_add_u32 s48, s40, 0x1008000
    s_waitcnt vmcnt(9)
    buffer_load_dwordx4 v[160:163], v1, s[20:23], s48 offen offset:0 nt
    buffer_load_dwordx4 v[164:167], v1, s[20:23], s48 offen offset:128 nt
    buffer_load_dwordx4 v[168:171], v1, s[20:23], s48 offen offset:256 nt
    buffer_load_dwordx4 v[172:175], v1, s[20:23], s48 offen offset:384 nt
    v_sub_u32 v42, v42, v9
    s_waitcnt vmcnt(16)
    v_mfma_f32_16x16x32_bf16 v[16:19], v[80:83], v[64:67], 0
    v_mfma_f32_16x16x32_bf16 v[20:23], v[96:99], v[64:67], 0
    v_mfma_f32_16x16x32_bf16 v[16:19], v[84:87], v[68:71], v[16:19]
    v_mfma_f32_16x16x32_bf16 v[20:23], v[100:103], v[68:71], v[20:23]
    v_mfma_f32_16x16x32_bf16 v[16:19], v[88:91], v[72:75], v[16:19]
    v_mfma_f32_16x16x32_bf16 v[20:23], v[104:107], v[72:75], v[20:23]
    v_mfma_f32_16x16x32_bf16 v[16:19], v[92:95], v[76:79], v[16:19]
    v_mfma_f32_16x16x32_bf16 v[20:23], v[108:111], v[76:79], v[20:23]
    v_cmp_lt_i32 s[52:53], 0, v42
    v_cmp_lt_i32 s[54:55], 1, v42
    v_cmp_lt_i32 s[56:57], 2, v42
    v_cmp_lt_i32 s[58:59], 3, v42
    v_cndmask_b32 v24, v41, v40, s[52:53]
    v_cndmask_b32 v25, v41, v40, s[54:55]
    v_cndmask_b32 v26, v41, v40, s[56:57]
    v_cndmask_b32 v27, v41, v40, s[58:59]
    v_permlane32_swap_b32 v16, v20
    v_permlane32_swap_b32 v17, v21
    v_permlane32_swap_b32 v18, v22
    v_permlane32_swap_b32 v19, v23
    v_add_f32_dpp v16, v20, v16 quad_perm:[1,0,3,2] row_mask:0xf bank_mask:0xf
    v_add_f32_dpp v17, v21, v17 quad_perm:[1,0,3,2] row_mask:0xf bank_mask:0xf
    v_add_f32_dpp v18, v22, v18 quad_perm:[1,0,3,2] row_mask:0xf bank_mask:0xf
    v_add_f32_dpp v19, v23, v19 quad_perm:[1,0,3,2] row_mask:0xf bank_mask:0xf
    v_cmp_lt_f32 s[52:53], v8, v24
    v_cmp_lt_f32 s[54:55], v8, v25
    v_cmp_lt_f32 s[56:57], v8, v26
    v_cmp_lt_f32 s[58:59], v8, v27
    v_cvt_pk_bf16_f32 v16, 0, v16
    v_cvt_pk_bf16_f32 v17, 0, v17
    v_cvt_pk_bf16_f32 v18, 0, v18
    v_cvt_pk_bf16_f32 v19, 0, v19
    v_cndmask_b32 v16, 0, v16, s[52:53]
    v_cndmask_b32 v17, 0, v17, s[54:55]
    v_cndmask_b32 v18, 0, v18, s[56:57]
    v_cndmask_b32 v19, 0, v19, s[58:59]
    v_fmac_f32_dpp v24, v16, v7 quad_perm:[0,0,2,2] row_mask:0xf bank_mask:0xf
    v_fmac_f32_dpp v25, v17, v7 quad_perm:[0,0,2,2] row_mask:0xf bank_mask:0xf
    v_fmac_f32_dpp v26, v18, v7 quad_perm:[0,0,2,2] row_mask:0xf bank_mask:0xf
    v_fmac_f32_dpp v27, v19, v7 quad_perm:[0,0,2,2] row_mask:0xf bank_mask:0xf
    v_max3_f32 v10, v10, v24, v25
    v_max3_f32 v10, v10, v26, v27
    s_mov_b32 s22, s47
    s_mov_b32 s48, s30
    s_waitcnt vmcnt(9)
    buffer_load_dwordx4 v[176:179], v1, s[20:23], s48 offen offset:0 nt
    buffer_load_dwordx4 v[180:183], v1, s[20:23], s48 offen offset:128 nt
    buffer_load_dwordx4 v[184:187], v1, s[20:23], s48 offen offset:256 nt
    buffer_load_dwordx4 v[188:191], v1, s[20:23], s48 offen offset:384 nt
    s_add_u32 s48, s30, s31
    s_mov_b32 s22, s32
    s_waitcnt vmcnt(9)
    buffer_load_dwordx4 v[192:195], v1, s[20:23], s48 offen offset:0 nt
    buffer_load_dwordx4 v[196:199], v1, s[20:23], s48 offen offset:128 nt
    buffer_load_dwordx4 v[200:203], v1, s[20:23], s48 offen offset:256 nt
    buffer_load_dwordx4 v[204:207], v1, s[20:23], s48 offen offset:384 nt
    v_and_b32 v3, 31, v0
    v_lshl_add_u32 v3, v3, 2, s39
    s_getreg_b32 s50, hwreg(HW_REG_XCC_ID, 0, 4)
    s_and_b32 s35, s38, 0xffffff
    s_lshl_b32 s50, s50, 24
    s_or_b32 s50, s50, s35
    global_load_dword v56, v3, s[16:17] offset:128 sc1
    v_sub_u32 v46, v46, v9
    s_waitcnt vmcnt(16)
    v_mfma_f32_16x16x32_bf16 v[16:19], v[112:115], v[64:67], 0
    v_mfma_f32_16x16x32_bf16 v[20:23], v[128:131], v[64:67], 0
    v_mfma_f32_16x16x32_bf16 v[16:19], v[116:119], v[68:71], v[16:19]
    v_mfma_f32_16x16x32_bf16 v[20:23], v[132:135], v[68:71], v[20:23]
    v_mfma_f32_16x16x32_bf16 v[16:19], v[120:123], v[72:75], v[16:19]
    v_mfma_f32_16x16x32_bf16 v[20:23], v[136:139], v[72:75], v[20:23]
    v_mfma_f32_16x16x32_bf16 v[16:19], v[124:127], v[76:79], v[16:19]
    v_mfma_f32_16x16x32_bf16 v[20:23], v[140:143], v[76:79], v[20:23]
    v_cmp_lt_i32 s[52:53], 0, v46
    v_cmp_lt_i32 s[54:55], 1, v46
    v_cmp_lt_i32 s[56:57], 2, v46
    v_cmp_lt_i32 s[58:59], 3, v46
    v_cndmask_b32 v28, v45, v44, s[52:53]
    v_cndmask_b32 v29, v45, v44, s[54:55]
    v_cndmask_b32 v30, v45, v44, s[56:57]
    v_cndmask_b32 v31, v45, v44, s[58:59]
    v_permlane32_swap_b32 v16, v20
    v_permlane32_swap_b32 v17, v21
    v_permlane32_swap_b32 v18, v22
    v_permlane32_swap_b32 v19, v23
    v_add_f32_dpp v16, v20, v16 quad_perm:[1,0,3,2] row_mask:0xf bank_mask:0xf
    v_add_f32_dpp v17, v21, v17 quad_perm:[1,0,3,2] row_mask:0xf bank_mask:0xf
    v_add_f32_dpp v18, v22, v18 quad_perm:[1,0,3,2] row_mask:0xf bank_mask:0xf
    v_add_f32_dpp v19, v23, v19 quad_perm:[1,0,3,2] row_mask:0xf bank_mask:0xf
    v_cmp_lt_f32 s[52:53], v8, v28
    v_cmp_lt_f32 s[54:55], v8, v29
    v_cmp_lt_f32 s[56:57], v8, v30
    v_cmp_lt_f32 s[58:59], v8, v31
    v_cvt_pk_bf16_f32 v16, 0, v16
    v_cvt_pk_bf16_f32 v17, 0, v17
    v_cvt_pk_bf16_f32 v18, 0, v18
    v_cvt_pk_bf16_f32 v19, 0, v19
    v_cndmask_b32 v16, 0, v16, s[52:53]
    v_cndmask_b32 v17, 0, v17, s[54:55]
    v_cndmask_b32 v18, 0, v18, s[56:57]
    v_cndmask_b32 v19, 0, v19, s[58:59]
    v_fmac_f32_dpp v28, v16, v7 quad_perm:[0,0,2,2] row_mask:0xf bank_mask:0xf
    v_fmac_f32_dpp v29, v17, v7 quad_perm:[0,0,2,2] row_mask:0xf bank_mask:0xf
    v_fmac_f32_dpp v30, v18, v7 quad_perm:[0,0,2,2] row_mask:0xf bank_mask:0xf
    v_fmac_f32_dpp v31, v19, v7 quad_perm:[0,0,2,2] row_mask:0xf bank_mask:0xf
    v_max3_f32 v10, v10, v28, v29
    v_max3_f32 v10, v10, v30, v31
    s_mov_b32 s26, s44
    s_waitcnt vmcnt(9)
    buffer_load_dwordx4 v[80:83], v2, s[24:27], s40 offen nt
    buffer_load_dwordx4 v[84:87], v210, s[24:27], s40 offen nt
    s_add_u32 s48, s40, 0x1000
    buffer_load_dwordx4 v[88:91], v2, s[24:27], s48 offen nt
    buffer_load_dwordx4 v[92:95], v210, s[24:27], s48 offen nt
    s_add_u32 s48, s40, 0x2000
    s_waitcnt vmcnt(9)
    buffer_load_dwordx4 v[96:99], v2, s[24:27], s48 offen nt
    buffer_load_dwordx4 v[100:103], v210, s[24:27], s48 offen nt
    s_add_u32 s48, s40, 0x3000
    buffer_load_dwordx4 v[104:107], v2, s[24:27], s48 offen nt
    buffer_load_dwordx4 v[108:111], v210, s[24:27], s48 offen nt
    s_lshl_b32 s35, s29, 1
    s_and_b32 s36, s3, 1
    s_add_u32 s35, s35, s36
    s_lshl_b32 s35, s35, 9
    s_add_u32 s35, s35, s28
    s_lshl_b32 s35, s35, 6
    s_add_u32 s35, s35, 0x10000
    v_and_b32 v1, 3, v0
    v_lshl_add_u32 v1, v1, 4, s35
    v_bfe_u32 v4, v0, 2, 4
    v_lshl_add_u32 v1, v4, 11, v1
    v_sub_u32 v50, v50, v9
    s_waitcnt vmcnt(16)
    v_mfma_f32_16x16x32_bf16 v[16:19], v[144:147], v[64:67], 0
    v_mfma_f32_16x16x32_bf16 v[20:23], v[160:163], v[64:67], 0
    v_mfma_f32_16x16x32_bf16 v[16:19], v[148:151], v[68:71], v[16:19]
    v_mfma_f32_16x16x32_bf16 v[20:23], v[164:167], v[68:71], v[20:23]
    v_mfma_f32_16x16x32_bf16 v[16:19], v[152:155], v[72:75], v[16:19]
    v_mfma_f32_16x16x32_bf16 v[20:23], v[168:171], v[72:75], v[20:23]
    v_mfma_f32_16x16x32_bf16 v[16:19], v[156:159], v[76:79], v[16:19]
    v_mfma_f32_16x16x32_bf16 v[20:23], v[172:175], v[76:79], v[20:23]
    v_cmp_lt_i32 s[52:53], 0, v50
    v_cmp_lt_i32 s[54:55], 1, v50
    v_cmp_lt_i32 s[56:57], 2, v50
    v_cmp_lt_i32 s[58:59], 3, v50
    v_cndmask_b32 v32, v49, v48, s[52:53]
    v_cndmask_b32 v33, v49, v48, s[54:55]
    v_cndmask_b32 v34, v49, v48, s[56:57]
    v_cndmask_b32 v35, v49, v48, s[58:59]
    v_permlane32_swap_b32 v16, v20
    v_permlane32_swap_b32 v17, v21
    v_permlane32_swap_b32 v18, v22
    v_permlane32_swap_b32 v19, v23
    v_add_f32_dpp v16, v20, v16 quad_perm:[1,0,3,2] row_mask:0xf bank_mask:0xf
    v_add_f32_dpp v17, v21, v17 quad_perm:[1,0,3,2] row_mask:0xf bank_mask:0xf
    v_add_f32_dpp v18, v22, v18 quad_perm:[1,0,3,2] row_mask:0xf bank_mask:0xf
    v_add_f32_dpp v19, v23, v19 quad_perm:[1,0,3,2] row_mask:0xf bank_mask:0xf
    v_cmp_lt_f32 s[52:53], v8, v32
    v_cmp_lt_f32 s[54:55], v8, v33
    v_cmp_lt_f32 s[56:57], v8, v34
    v_cmp_lt_f32 s[58:59], v8, v35
    v_cvt_pk_bf16_f32 v16, 0, v16
    v_cvt_pk_bf16_f32 v17, 0, v17
    v_cvt_pk_bf16_f32 v18, 0, v18
    v_cvt_pk_bf16_f32 v19, 0, v19
    v_cndmask_b32 v16, 0, v16, s[52:53]
    v_cndmask_b32 v17, 0, v17, s[54:55]
    v_cndmask_b32 v18, 0, v18, s[56:57]
    v_cndmask_b32 v19, 0, v19, s[58:59]
    v_fmac_f32_dpp v32, v16, v7 quad_perm:[0,0,2,2] row_mask:0xf bank_mask:0xf
    v_fmac_f32_dpp v33, v17, v7 quad_perm:[0,0,2,2] row_mask:0xf bank_mask:0xf
    v_fmac_f32_dpp v34, v18, v7 quad_perm:[0,0,2,2] row_mask:0xf bank_mask:0xf
    v_fmac_f32_dpp v35, v19, v7 quad_perm:[0,0,2,2] row_mask:0xf bank_mask:0xf
    v_max3_f32 v10, v10, v32, v33
    v_max3_f32 v10, v10, v34, v35
    s_branch Lm_c
.p2align 12
Lh_merge:
    s_lshl_b32 s34, s29, 5
    s_add_u32 s34, s34, s28
    s_lshl_b32 s34, s34, 11
    s_add_u32 s34, s34, 0x10000
    v_add_u32 v3, s34, v1
    s_bfe_u32 s36, s28, 0x10003
    v_lshrrev_b32 v4, 2, v0
    v_lshlrev_b32 v4, 4, v4
    s_lshl_b32 s35, s36, 8
    s_add_u32 s35, s35, s39
    v_add_u32 v4, s35, v4
    global_load_dwordx4 v[40:43], v4, s[16:17] offset:512 sc1
    s_lshl_b32 s35, s36, 9
    s_add_u32 s35, s35, s39
    s_bfe_u32 s36, s28, 0x10004
    s_lshl_b32 s36, s36, 8
    s_add_u32 s35, s35, s36
    s_and_b32 s36, s28, 3
    s_lshl_b32 s36, s36, 6
    s_add_u32 s35, s35, s36
    s_bfe_u32 s36, s28, 0x10002
    s_lshl_b32 s36, s36, 3
    s_add_u32 s35, s35, s36
    v_lshl_add_u32 v5, v6, 4, s35
    v_bfe_u32 v7, v0, 5, 1
    v_lshl_add_u32 v5, v7, 1, v5
    v_bfe_u32 v7, v0, 4, 1
    v_lshl_add_u32 v5, v7, 2, v5
    s_mov_b32 s42, 0x000f000f
    s_mov_b32 s43, 0x000f000f
    s_mov_b32 s52, 0x0c0c0400
    s_mov_b32 s53, 0x04000c0c
    s_mov_b32 s54, 0xffffff00
    s_mov_b32 s49, 0
    v_mov_b32 v2, s39
    v_mov_b32 v7, s41
    s_barrier
    s_barrier
    s_barrier
Lh_lse:
    global_load_dwordx4 v[40:43], v4, s[16:17] offset:512 sc1
    s_add_u32 s49, s49, 0x400
    s_cbranch_scc1 Lh_lse_ok
    s_waitcnt vmcnt(0)
    v_cmp_ne_u32 s[56:57], s38, v41
    v_cmp_ne_u32 vcc, s38, v43
    s_or_b64 vcc, vcc, s[56:57]
    s_cbranch_scc1 Lh_lse
Lh_lse_ok:
    s_waitcnt vmcnt(0)
    global_load_dwordx4 v[32:35], v3, s[16:17] sc1
    global_load_dwordx4 v[36:39], v3, s[16:17] offset:1024 sc1
    v_max_f32 v9, v40, v42
    s_nop 1
    v_max_f32_dpp v9, v9, v9 row_ror:4 row_mask:0xf bank_mask:0xf
    s_nop 1
    v_max_f32_dpp v9, v9, v9 row_ror:8 row_mask:0xf bank_mask:0xf
    v_mov_b32 v10, v9
    s_nop 1
    v_permlane16_swap_b32 v9, v10
    v_max_f32 v9, v9, v10
    v_mov_b32 v10, v9
    s_nop 1
    v_permlane32_swap_b32 v9, v10
    v_max_f32 v9, v9, v10
    v_sub_f32 v40, v40, v9
    v_sub_f32 v42, v42, v9
    v_exp_f32 v40, v40
    v_exp_f32 v42, v42
    s_mov_b32 s49, 0
    v_add_f32 v9, v40, v42
    global_load_dwordx4 v[44:47], v3, s[16:17] sc1
    global_load_dwordx4 v[48:51], v3, s[16:17] offset:1024 sc1
    s_nop 1
    v_add_f32_dpp v9, v9, v9 row_ror:4 row_mask:0xf bank_mask:0xf
    s_nop 1
    v_add_f32_dpp v9, v9, v9 row_ror:8 row_mask:0xf bank_mask:0xf
    v_mov_b32 v10, v9
    s_nop 1
    v_permlane16_swap_b32 v9, v10
    v_add_f32 v9, v9, v10
    v_mov_b32 v10, v9
    s_nop 1
    v_permlane32_swap_b32 v9, v10
    v_add_f32 v9, v9, v10
    v_rcp_f32 v9, v9
    s_nop 0
    v_mul_f32 v40, v40, v9
    v_mul_f32 v42, v42, v9
    v_mov_b32 v41, v40
    v_mov_b32 v43, v42
Lh_poll:
    s_waitcnt vmcnt(3)
    v_perm_b32 v9, v33, v32, s52
    v_perm_b32 v10, v35, v34, s53
    v_or_b32 v9, v9, v10
    v_cmp_ne_u32 s[56:57], s38, v9
    s_waitcnt vmcnt(2)
    v_perm_b32 v9, v37, v36, s52
    v_perm_b32 v10, v39, v38, s53
    v_or_b32 v9, v9, v10
    v_cmp_ne_u32 vcc, s38, v9
    s_or_b64 vcc, vcc, s[56:57]
    s_cbranch_scc0 Lh_ready
    global_load_dwordx4 v[32:35], v3, s[16:17] sc1
    global_load_dwordx4 v[36:39], v3, s[16:17] offset:1024 sc1
    s_waitcnt vmcnt(3)
    v_perm_b32 v9, v45, v44, s52
    v_perm_b32 v10, v47, v46, s53
    v_or_b32 v9, v9, v10
    v_cmp_ne_u32 s[56:57], s38, v9
    s_waitcnt vmcnt(2)
    v_perm_b32 v9, v49, v48, s52
    v_perm_b32 v10, v51, v50, s53
    v_or_b32 v9, v9, v10
    v_cmp_ne_u32 vcc, s38, v9
    s_or_b64 vcc, vcc, s[56:57]
    s_cbranch_scc0 Lh_ready2
    global_load_dwordx4 v[44:47], v3, s[16:17] sc1
    global_load_dwordx4 v[48:51], v3, s[16:17] offset:1024 sc1
    s_add_u32 s49, s49, 1
    s_bitcmp0_b32 s49, 22
    s_cbranch_scc1 Lh_poll
Lh_ready2:
    v_and_b32 v16, s54, v44
    v_and_b32 v17, s54, v45
    v_and_b32 v18, s54, v46
    v_and_b32 v19, s54, v47
    v_and_b32 v20, s54, v48
    v_and_b32 v21, s54, v49
    v_and_b32 v22, s54, v50
    v_and_b32 v23, s54, v51
    s_branch Lh_sum
Lh_ready:
    v_and_b32 v16, s54, v32
    v_and_b32 v17, s54, v33
    v_and_b32 v18, s54, v34
    v_and_b32 v19, s54, v35
    v_and_b32 v20, s54, v36
    v_and_b32 v21, s54, v37
    v_and_b32 v22, s54, v38
    v_and_b32 v23, s54, v39
Lh_sum:
    v_pk_mul_f32 v[12:13], v[40:41], v[16:17]
    v_pk_mul_f32 v[14:15], v[40:41], v[18:19]
    v_pk_fma_f32 v[12:13], v[42:43], v[20:21], v[12:13]
    v_pk_fma_f32 v[14:15], v[42:43], v[22:23], v[14:15]
    s_cmp_eq_u32 s28, 0
    v_permlane32_swap_b32 v12, v13
    v_permlane32_swap_b32 v14, v15
    v_add_f32 v12, v12, v13
    v_add_f32 v14, v14, v15
    s_nop 1
    v_permlane16_swap_b32 v12, v14
    v_add_f32 v12, v12, v14
    s_nop 1
    v_add_f32_dpp v12, v12, v12 row_ror:4 row_mask:0xf bank_mask:0xf
    s_nop 1
    v_add_f32_dpp v12, v12, v12 row_ror:8 row_mask:0xf bank_mask:0xf
    s_mov_b64 exec, s[42:43]
    v_cvt_pk_bf16_f32 v12, v12, v12
    global_store_short v5, v12, s[12:13]
    s_cbranch_scc0 Lh_end
    s_mov_b64 exec, 1
    global_store_dword v2, v7, s[16:17]
Lh_end:
    s_endpgm
Lm_c:
    s_mov_b32 s26, s45
    s_add_u32 s48, s40, 0x800000
    s_waitcnt vmcnt(9)
    buffer_load_dwordx4 v[112:115], v2, s[24:27], s48 offen nt
    buffer_load_dwordx4 v[116:119], v210, s[24:27], s48 offen nt
    s_add_u32 s48, s40, 0x801000
    buffer_load_dwordx4 v[120:123], v2, s[24:27], s48 offen nt
    buffer_load_dwordx4 v[124:127], v210, s[24:27], s48 offen nt
    s_add_u32 s48, s40, 0x802000
    s_waitcnt vmcnt(9)
    buffer_load_dwordx4 v[128:131], v2, s[24:27], s48 offen nt
    buffer_load_dwordx4 v[132:135], v210, s[24:27], s48 offen nt
    s_add_u32 s48, s40, 0x803000
    buffer_load_dwordx4 v[136:139], v2, s[24:27], s48 offen nt
    buffer_load_dwordx4 v[140:143], v210, s[24:27], s48 offen nt
    s_waitcnt vmcnt(16)
    v_cmp_ne_u32 vcc, s50, v56
    s_cmp_eq_u64 vcc, 0
    s_cselect_b32 s51, 1, 0
    v_sub_u32 v54, v54, v208
    s_waitcnt vmcnt(16)
    v_mfma_f32_16x16x32_bf16 v[16:19], v[176:179], v[64:67], 0
    v_mfma_f32_16x16x32_bf16 v[20:23], v[192:195], v[64:67], 0
    v_mfma_f32_16x16x32_bf16 v[16:19], v[180:183], v[68:71], v[16:19]
    v_mfma_f32_16x16x32_bf16 v[20:23], v[196:199], v[68:71], v[20:23]
    v_mfma_f32_16x16x32_bf16 v[16:19], v[184:187], v[72:75], v[16:19]
    v_mfma_f32_16x16x32_bf16 v[20:23], v[200:203], v[72:75], v[20:23]
    v_mfma_f32_16x16x32_bf16 v[16:19], v[188:191], v[76:79], v[16:19]
    v_mfma_f32_16x16x32_bf16 v[20:23], v[204:207], v[76:79], v[20:23]
    v_cmp_lt_i32 s[52:53], 0, v54
    v_cmp_lt_i32 s[54:55], 1, v54
    v_cmp_lt_i32 s[56:57], 2, v54
    v_cmp_lt_i32 s[58:59], 3, v54
    v_cndmask_b32 v36, v53, v52, s[52:53]
    v_cndmask_b32 v37, v53, v52, s[54:55]
    v_cndmask_b32 v38, v53, v52, s[56:57]
    v_cndmask_b32 v39, v53, v52, s[58:59]
    v_permlane32_swap_b32 v16, v20
    v_permlane32_swap_b32 v17, v21
    v_permlane32_swap_b32 v18, v22
    v_permlane32_swap_b32 v19, v23
    v_add_f32_dpp v16, v20, v16 quad_perm:[1,0,3,2] row_mask:0xf bank_mask:0xf
    v_add_f32_dpp v17, v21, v17 quad_perm:[1,0,3,2] row_mask:0xf bank_mask:0xf
    v_add_f32_dpp v18, v22, v18 quad_perm:[1,0,3,2] row_mask:0xf bank_mask:0xf
    v_add_f32_dpp v19, v23, v19 quad_perm:[1,0,3,2] row_mask:0xf bank_mask:0xf
    v_cmp_lt_f32 s[52:53], v8, v36
    v_cmp_lt_f32 s[54:55], v8, v37
    v_cmp_lt_f32 s[56:57], v8, v38
    v_cmp_lt_f32 s[58:59], v8, v39
    v_cvt_pk_bf16_f32 v16, 0, v16
    v_cvt_pk_bf16_f32 v17, 0, v17
    v_cvt_pk_bf16_f32 v18, 0, v18
    v_cvt_pk_bf16_f32 v19, 0, v19
    v_cndmask_b32 v16, 0, v16, s[52:53]
    v_cndmask_b32 v17, 0, v17, s[54:55]
    v_cndmask_b32 v18, 0, v18, s[56:57]
    v_cndmask_b32 v19, 0, v19, s[58:59]
    v_fmac_f32_dpp v36, v16, v7 quad_perm:[0,0,2,2] row_mask:0xf bank_mask:0xf
    v_fmac_f32_dpp v37, v17, v7 quad_perm:[0,0,2,2] row_mask:0xf bank_mask:0xf
    v_fmac_f32_dpp v38, v18, v7 quad_perm:[0,0,2,2] row_mask:0xf bank_mask:0xf
    v_fmac_f32_dpp v39, v19, v7 quad_perm:[0,0,2,2] row_mask:0xf bank_mask:0xf
    v_max3_f32 v10, v10, v36, v37
    v_max3_f32 v10, v10, v38, v39
    s_cmp_lt_u32 s3, 2
    s_cbranch_scc1 Lm_v2pub
    s_mov_b32 s26, s46
    s_add_u32 s48, s40, 0x1000000
    s_waitcnt vmcnt(9)
    buffer_load_dwordx4 v[144:147], v2, s[24:27], s48 offen nt
    buffer_load_dwordx4 v[148:151], v210, s[24:27], s48 offen nt
    s_add_u32 s48, s40, 0x1001000
    buffer_load_dwordx4 v[152:155], v2, s[24:27], s48 offen nt
    buffer_load_dwordx4 v[156:159], v210, s[24:27], s48 offen nt
    s_add_u32 s48, s40, 0x1002000
    s_waitcnt vmcnt(9)
    buffer_load_dwordx4 v[160:163], v2, s[24:27], s48 offen nt
    buffer_load_dwordx4 v[164:167], v210, s[24:27], s48 offen nt
    s_add_u32 s48, s40, 0x1003000
    buffer_load_dwordx4 v[168:171], v2, s[24:27], s48 offen nt
    buffer_load_dwordx4 v[172:175], v210, s[24:27], s48 offen nt
    s_branch Lm_v2done
Lm_v2pub:
    s_mov_b32 s26, s46
    s_waitcnt vmcnt(9)
    s_add_u32 s48, s40, 0x1000000
    buffer_load_dwordx4 v[144:147], v2, s[24:27], s48 offen nt
    s_add_u32 s48, s40, 0x1001000
    buffer_load_dwordx4 v[152:155], v2, s[24:27], s48 offen nt
    s_add_u32 s48, s40, 0x1002000
    buffer_load_dwordx4 v[160:163], v2, s[24:27], s48 offen nt
    s_add_u32 s48, s40, 0x1003000
    buffer_load_dwordx4 v[168:171], v2, s[24:27], s48 offen nt
    s_mov_b32 s26, 0x2000000
    s_waitcnt vmcnt(9)
    s_add_u32 s48, s30, 0x0
    buffer_load_dwordx4 v[176:179], v209, s[24:27], s48 offen nt
    s_add_u32 s48, s30, 0x1000
    buffer_load_dwordx4 v[184:187], v209, s[24:27], s48 offen nt
    s_add_u32 s48, s30, 0x2000
    buffer_load_dwordx4 v[192:195], v209, s[24:27], s48 offen nt
    s_add_u32 s48, s30, 0x3000
    buffer_load_dwordx4 v[200:203], v209, s[24:27], s48 offen nt
Lm_v2done:
    v_mov_b32 v3, v10
    s_nop 1
    v_permlane16_swap_b32 v10, v3
    v_max_f32 v10, v10, v3
    v_mov_b32 v3, v10
    s_nop 1
    v_permlane32_swap_b32 v10, v3
    v_max_f32 v10, v10, v3
    v_sub_f32 v24, v24, v10
    v_sub_f32 v25, v25, v10
    v_sub_f32 v26, v26, v10
    v_sub_f32 v27, v27, v10
    v_sub_f32 v28, v28, v10
    v_sub_f32 v29, v29, v10
    v_sub_f32 v30, v30, v10
    v_sub_f32 v31, v31, v10
    v_sub_f32 v32, v32, v10
    v_sub_f32 v33, v33, v10
    v_sub_f32 v34, v34, v10
    v_sub_f32 v35, v35, v10
    v_sub_f32 v36, v36, v10
    v_sub_f32 v37, v37, v10
    v_sub_f32 v38, v38, v10
    v_sub_f32 v39, v39, v10
    v_exp_f32 v24, v24
    v_exp_f32 v25, v25
    v_exp_f32 v26, v26
    v_exp_f32 v27, v27
    v_exp_f32 v28, v28
    v_exp_f32 v29, v29
    v_exp_f32 v30, v30
    v_exp_f32 v31, v31
    v_exp_f32 v32, v32
    v_exp_f32 v33, v33
    v_exp_f32 v34, v34
    v_exp_f32 v35, v35
    v_exp_f32 v36, v36
    v_exp_f32 v37, v37
    v_exp_f32 v38, v38
    v_exp_f32 v39, v39
    v_add_f32 v11, v24, v25
    v_add_f32 v4, v26, v27
    v_add_f32 v11, v11, v28
    v_add_f32 v4, v4, v29
    v_add_f32 v11, v11, v30
    v_add_f32 v4, v4, v31
    v_add_f32 v11, v11, v32
    v_add_f32 v4, v4, v33
    v_add_f32 v11, v11, v34
    v_add_f32 v4, v4, v35
    v_add_f32 v11, v11, v36
    v_add_f32 v4, v4, v37
    v_add_f32 v11, v11, v38
    v_add_f32 v4, v4, v39
    v_add_f32 v11, v11, v4
    v_mov_b32 v3, v11
    s_nop 1
    v_permlane16_swap_b32 v11, v3
    v_add_f32 v11, v11, v3
    v_mov_b32 v3, v11
    s_nop 1
    v_permlane32_swap_b32 v11, v3
    v_add_f32 v11, v11, v3
    v_lshrrev_b32 v16, 3, v5
    v_lshlrev_b32 v3, 5, v16
    s_lshl_b32 s35, s3, 3
    v_add_u32 v4, s35, v3
    ds_write_b64 v4, v[10:11] offset:0
    s_and_b32 s35, s28, 15
    s_lshl_b32 s35, s35, 4
    s_lshr_b32 s36, s28, 4
    s_lshl_b32 s36, s36, 3
    s_add_u32 s35, s35, s36
    s_add_u32 s35, s35, s39
    v_lshl_add_u32 v16, v16, 8, s35
    v_mov_b32 v7, s38
    s_waitcnt lgkmcnt(0)
    s_barrier
    ds_read_b128 v[40:43], v3 offset:0
    ds_read_b128 v[44:47], v3 offset:16
    s_waitcnt lgkmcnt(0)
    v_max3_f32 v3, v40, v42, v44
    v_max_f32 v3, v3, v46
    v_sub_f32 v40, v40, v3
    v_sub_f32 v42, v42, v3
    v_sub_f32 v44, v44, v3
    v_sub_f32 v46, v46, v3
    v_sub_f32 v10, v10, v3
    v_exp_f32 v40, v40
    v_exp_f32 v42, v42
    v_exp_f32 v44, v44
    v_exp_f32 v46, v46
    v_exp_f32 v10, v10
    v_mul_f32 v11, v40, v41
    v_fmac_f32 v11, v42, v43
    v_fmac_f32 v11, v44, v45
    v_fmac_f32 v11, v46, v47
    v_max_f32 v4, 1.0, v11
    v_log_f32 v11, v11
    v_rcp_f32 v4, v4
    v_add_f32 v20, v11, v3
    v_mul_f32 v10, v10, v4
    v_mov_b32 v21, s38
    v_mul_f32 v24, v24, v10
    v_mul_f32 v25, v25, v10
    v_mul_f32 v26, v26, v10
    v_mul_f32 v27, v27, v10
    v_mul_f32 v28, v28, v10
    v_mul_f32 v29, v29, v10
    v_mul_f32 v30, v30, v10
    v_mul_f32 v31, v31, v10
    v_mul_f32 v32, v32, v10
    v_mul_f32 v33, v33, v10
    v_mul_f32 v34, v34, v10
    v_mul_f32 v35, v35, v10
    v_mul_f32 v36, v36, v10
    v_mul_f32 v37, v37, v10
    v_mul_f32 v38, v38, v10
    v_mul_f32 v39, v39, v10
    v_cvt_pk_bf16_f32 v24, v24, v24
    v_cvt_pk_bf16_f32 v25, v25, v25
    v_cvt_pk_bf16_f32 v26, v26, v26
    v_cvt_pk_bf16_f32 v27, v27, v27
    v_cvt_pk_bf16_f32 v28, v28, v28
    v_cvt_pk_bf16_f32 v29, v29, v29
    v_cvt_pk_bf16_f32 v30, v30, v30
    v_cvt_pk_bf16_f32 v31, v31, v31
    v_cvt_pk_bf16_f32 v32, v32, v32
    v_cvt_pk_bf16_f32 v33, v33, v33
    v_cvt_pk_bf16_f32 v34, v34, v34
    v_cvt_pk_bf16_f32 v35, v35, v35
    v_cvt_pk_bf16_f32 v36, v36, v36
    v_cvt_pk_bf16_f32 v37, v37, v37
    v_cvt_pk_bf16_f32 v38, v38, v38
    v_cvt_pk_bf16_f32 v39, v39, v39
    v_and_b32 v40, v24, v12
    v_and_b32 v41, v24, v13
    v_and_b32 v42, v24, v14
    v_and_b32 v43, v24, v15
    v_and_b32 v44, v25, v12
    v_and_b32 v45, v25, v13
    v_and_b32 v46, v25, v14
    v_and_b32 v47, v25, v15
    v_and_b32 v48, v26, v12
    v_and_b32 v49, v26, v13
    v_and_b32 v50, v26, v14
    v_and_b32 v51, v26, v15
    v_and_b32 v52, v27, v12
    v_and_b32 v53, v27, v13
    v_and_b32 v54, v27, v14
    v_and_b32 v55, v27, v15
    s_cmp_lg_u32 s3, 3
    s_cbranch_scc1 Lm_nolse
    s_mov_b64 exec, 0x101
    s_cmp_lg_u32 s51, 0
    s_cbranch_scc0 Lm_lse_far
    global_store_dwordx2 v16, v[20:21], s[16:17] offset:512
    s_branch Lm_lse_done
Lm_lse_far:
    global_store_dwordx2 v16, v[20:21], s[16:17] offset:512 sc1
Lm_lse_done:
    s_mov_b64 exec, -1
Lm_nolse:
    s_waitcnt vmcnt(16)
    v_mfma_f32_16x16x32_bf16 v[56:59], v[40:43], v[80:83], 0
    v_mfma_f32_16x16x32_bf16 v[60:63], v[40:43], v[84:87], 0
    v_mfma_f32_16x16x32_bf16 v[56:59], v[44:47], v[88:91], v[56:59]
    v_mfma_f32_16x16x32_bf16 v[60:63], v[44:47], v[92:95], v[60:63]
    v_mfma_f32_16x16x32_bf16 v[56:59], v[48:51], v[96:99], v[56:59]
    v_mfma_f32_16x16x32_bf16 v[60:63], v[48:51], v[100:103], v[60:63]
    v_mfma_f32_16x16x32_bf16 v[56:59], v[52:55], v[104:107], v[56:59]
    v_mfma_f32_16x16x32_bf16 v[60:63], v[52:55], v[108:111], v[60:63]
    s_lshl_b32 s35, s29, 5
    s_add_u32 s35, s35, s28
    s_lshl_b32 s35, s35, 2
    s_add_u32 s35, s35, s3
    s_lshl_b32 s35, s35, 9
    s_add_u32 s35, s35, 0x10000
    v_lshl_add_u32 v3, v5, 7, s35
    v_and_b32 v8, 63, v0
    v_lshlrev_b32 v8, 4, v8
    s_cmp_lt_u32 s3, 2
    s_cbranch_scc1 Lm_pub
    s_mov_b32 s26, 0x2000000
    s_add_u32 s48, s30, 0x0
    s_waitcnt vmcnt(9)
    buffer_load_dwordx4 v[176:179], v209, s[24:27], s48 offen nt
    buffer_load_dwordx4 v[180:183], v211, s[24:27], s48 offen nt
    s_add_u32 s48, s30, 0x1000
    buffer_load_dwordx4 v[184:187], v209, s[24:27], s48 offen nt
    buffer_load_dwordx4 v[188:191], v211, s[24:27], s48 offen nt
    s_add_u32 s48, s30, 0x2000
    s_waitcnt vmcnt(9)
    buffer_load_dwordx4 v[192:195], v209, s[24:27], s48 offen nt
    buffer_load_dwordx4 v[196:199], v211, s[24:27], s48 offen nt
    s_add_u32 s48, s30, 0x3000
    buffer_load_dwordx4 v[200:203], v209, s[24:27], s48 offen nt
    buffer_load_dwordx4 v[204:207], v211, s[24:27], s48 offen nt
    s_mov_b64 exec, 15
    global_load_dword v4, v3, s[16:17] sc1
    s_mov_b64 exec, -1
    s_barrier
    s_lshl_b32 s35, s3, 10
    v_add_u32 v8, s35, v8
    v_and_b32 v40, v28, v12
    v_and_b32 v41, v28, v13
    v_and_b32 v42, v28, v14
    v_and_b32 v43, v28, v15
    v_and_b32 v44, v29, v12
    v_and_b32 v45, v29, v13
    v_and_b32 v46, v29, v14
    v_and_b32 v47, v29, v15
    v_and_b32 v48, v30, v12
    v_and_b32 v49, v30, v13
    v_and_b32 v50, v30, v14
    v_and_b32 v51, v30, v15
    v_and_b32 v52, v31, v12
    v_and_b32 v53, v31, v13
    v_and_b32 v54, v31, v14
    v_and_b32 v55, v31, v15
    s_waitcnt vmcnt(17)
    v_mfma_f32_16x16x32_bf16 v[56:59], v[40:43], v[112:115], v[56:59]
    v_mfma_f32_16x16x32_bf16 v[60:63], v[40:43], v[116:119], v[60:63]
    v_mfma_f32_16x16x32_bf16 v[56:59], v[44:47], v[120:123], v[56:59]
    v_mfma_f32_16x16x32_bf16 v[60:63], v[44:47], v[124:127], v[60:63]
    v_mfma_f32_16x16x32_bf16 v[56:59], v[48:51], v[128:131], v[56:59]
    v_mfma_f32_16x16x32_bf16 v[60:63], v[48:51], v[132:135], v[60:63]
    v_mfma_f32_16x16x32_bf16 v[56:59], v[52:55], v[136:139], v[56:59]
    v_mfma_f32_16x16x32_bf16 v[60:63], v[52:55], v[140:143], v[60:63]
    v_and_b32 v40, v32, v12
    v_and_b32 v41, v32, v13
    v_and_b32 v42, v32, v14
    v_and_b32 v43, v32, v15
    v_and_b32 v44, v33, v12
    v_and_b32 v45, v33, v13
    v_and_b32 v46, v33, v14
    v_and_b32 v47, v33, v15
    v_and_b32 v48, v34, v12
    v_and_b32 v49, v34, v13
    v_and_b32 v50, v34, v14
    v_and_b32 v51, v34, v15
    v_and_b32 v52, v35, v12
    v_and_b32 v53, v35, v13
    v_and_b32 v54, v35, v14
    v_and_b32 v55, v35, v15
    s_waitcnt vmcnt(9)
    v_mfma_f32_16x16x32_bf16 v[56:59], v[40:43], v[144:147], v[56:59]
    v_mfma_f32_16x16x32_bf16 v[60:63], v[40:43], v[148:151], v[60:63]
    v_mfma_f32_16x16x32_bf16 v[56:59], v[44:47], v[152:155], v[56:59]
    v_mfma_f32_16x16x32_bf16 v[60:63], v[44:47], v[156:159], v[60:63]
    v_mfma_f32_16x16x32_bf16 v[56:59], v[48:51], v[160:163], v[56:59]
    v_mfma_f32_16x16x32_bf16 v[60:63], v[48:51], v[164:167], v[60:63]
    v_mfma_f32_16x16x32_bf16 v[56:59], v[52:55], v[168:171], v[56:59]
    v_mfma_f32_16x16x32_bf16 v[60:63], v[52:55], v[172:175], v[60:63]
    v_and_b32 v40, v36, v12
    v_and_b32 v41, v36, v13
    v_and_b32 v42, v36, v14
    v_and_b32 v43, v36, v15
    v_and_b32 v44, v37, v12
    v_and_b32 v45, v37, v13
    v_and_b32 v46, v37, v14
    v_and_b32 v47, v37, v15
    v_and_b32 v48, v38, v12
    v_and_b32 v49, v38, v13
    v_and_b32 v50, v38, v14
    v_and_b32 v51, v38, v15
    v_and_b32 v52, v39, v12
    v_and_b32 v53, v39, v13
    v_and_b32 v54, v39, v14
    v_and_b32 v55, v39, v15
    s_waitcnt vmcnt(8)
    v_mfma_f32_16x16x32_bf16 v[56:59], v[40:43], v[176:179], v[56:59]
    s_waitcnt vmcnt(7)
    v_mfma_f32_16x16x32_bf16 v[60:63], v[40:43], v[180:183], v[60:63]
    s_waitcnt vmcnt(6)
    v_mfma_f32_16x16x32_bf16 v[56:59], v[44:47], v[184:187], v[56:59]
    s_waitcnt vmcnt(5)
    v_mfma_f32_16x16x32_bf16 v[60:63], v[44:47], v[188:191], v[60:63]
    s_waitcnt vmcnt(4)
    v_mfma_f32_16x16x32_bf16 v[56:59], v[48:51], v[192:195], v[56:59]
    s_waitcnt vmcnt(3)
    v_mfma_f32_16x16x32_bf16 v[60:63], v[48:51], v[196:199], v[60:63]
    s_waitcnt vmcnt(2)
    v_mfma_f32_16x16x32_bf16 v[56:59], v[52:55], v[200:203], v[56:59]
    s_waitcnt vmcnt(1)
    v_mfma_f32_16x16x32_bf16 v[60:63], v[52:55], v[204:207], v[60:63]
    s_nop 5
    ds_write_b128 v8, v[56:59] offset:0
    s_nop 0
    ds_write_b128 v8, v[60:63] offset:3072
    s_waitcnt lgkmcnt(0)
    s_barrier
Lm_end:
    s_endpgm
Lm_pub:
    s_barrier
    s_mov_b32 s26, s46
    s_waitcnt vmcnt(9)
    s_add_u32 s48, s40, 0x1000000
    buffer_load_dwordx4 v[148:151], v210, s[24:27], s48 offen nt
    s_add_u32 s48, s40, 0x1001000
    buffer_load_dwordx4 v[156:159], v210, s[24:27], s48 offen nt
    s_add_u32 s48, s40, 0x1002000
    buffer_load_dwordx4 v[164:167], v210, s[24:27], s48 offen nt
    s_add_u32 s48, s40, 0x1003000
    buffer_load_dwordx4 v[172:175], v210, s[24:27], s48 offen nt
    s_mov_b32 s26, 0x2000000
    s_waitcnt vmcnt(9)
    s_add_u32 s48, s30, 0x0
    buffer_load_dwordx4 v[180:183], v211, s[24:27], s48 offen nt
    s_add_u32 s48, s30, 0x1000
    buffer_load_dwordx4 v[188:191], v211, s[24:27], s48 offen nt
    s_add_u32 s48, s30, 0x2000
    buffer_load_dwordx4 v[196:199], v211, s[24:27], s48 offen nt
    s_add_u32 s48, s30, 0x3000
    buffer_load_dwordx4 v[204:207], v211, s[24:27], s48 offen nt
    s_mov_b64 exec, 15
    global_load_dword v4, v3, s[16:17] sc1
    s_mov_b64 exec, -1
    s_mul_i32 s35, s3, 3072
    v_add_u32 v9, s35, v8
    s_sub_u32 s35, 3072, s35
    v_add_u32 v8, s35, v8
    s_mov_b32 s52, 0x07060500
    s_mov_b32 s53, 0x07060501
    s_mov_b32 s54, 0x07060502
    s_mov_b32 s55, 0x07060503
    v_and_b32 v40, v28, v12
    v_and_b32 v41, v28, v13
    v_and_b32 v42, v28, v14
    v_and_b32 v43, v28, v15
    v_and_b32 v44, v29, v12
    v_and_b32 v45, v29, v13
    v_and_b32 v46, v29, v14
    v_and_b32 v47, v29, v15
    v_and_b32 v48, v30, v12
    v_and_b32 v49, v30, v13
    v_and_b32 v50, v30, v14
    v_and_b32 v51, v30, v15
    v_and_b32 v52, v31, v12
    v_and_b32 v53, v31, v13
    v_and_b32 v54, v31, v14
    v_and_b32 v55, v31, v15
    s_waitcnt vmcnt(17)
    v_mfma_f32_16x16x32_bf16 v[56:59], v[40:43], v[112:115], v[56:59]
    v_mfma_f32_16x16x32_bf16 v[60:63], v[40:43], v[116:119], v[60:63]
    v_mfma_f32_16x16x32_bf16 v[56:59], v[44:47], v[120:123], v[56:59]
    v_mfma_f32_16x16x32_bf16 v[60:63], v[44:47], v[124:127], v[60:63]
    v_mfma_f32_16x16x32_bf16 v[56:59], v[48:51], v[128:131], v[56:59]
    v_mfma_f32_16x16x32_bf16 v[60:63], v[48:51], v[132:135], v[60:63]
    v_mfma_f32_16x16x32_bf16 v[56:59], v[52:55], v[136:139], v[56:59]
    v_mfma_f32_16x16x32_bf16 v[60:63], v[52:55], v[140:143], v[60:63]
    v_and_b32 v40, v32, v12
    v_and_b32 v41, v32, v13
    v_and_b32 v42, v32, v14
    v_and_b32 v43, v32, v15
    v_and_b32 v44, v33, v12
    v_and_b32 v45, v33, v13
    v_and_b32 v46, v33, v14
    v_and_b32 v47, v33, v15
    v_and_b32 v48, v34, v12
    v_and_b32 v49, v34, v13
    v_and_b32 v50, v34, v14
    v_and_b32 v51, v34, v15
    v_and_b32 v52, v35, v12
    v_and_b32 v53, v35, v13
    v_and_b32 v54, v35, v14
    v_and_b32 v55, v35, v15
    v_and_b32 v64, v36, v12
    v_and_b32 v65, v36, v13
    v_and_b32 v66, v36, v14
    v_and_b32 v67, v36, v15
    v_and_b32 v68, v37, v12
    v_and_b32 v69, v37, v13
    v_and_b32 v70, v37, v14
    v_and_b32 v71, v37, v15
    v_and_b32 v72, v38, v12
    v_and_b32 v73, v38, v13
    v_and_b32 v74, v38, v14
    v_and_b32 v75, v38, v15
    v_and_b32 v76, v39, v12
    v_and_b32 v77, v39, v13
    v_and_b32 v78, v39, v14
    v_and_b32 v79, v39, v15
    s_waitcnt vmcnt(9)
    v_mfma_f32_16x16x32_bf16 v[56:59], v[40:43], v[144:147], v[56:59]
    v_mfma_f32_16x16x32_bf16 v[56:59], v[44:47], v[152:155], v[56:59]
    v_mfma_f32_16x16x32_bf16 v[56:59], v[48:51], v[160:163], v[56:59]
    v_mfma_f32_16x16x32_bf16 v[56:59], v[52:55], v[168:171], v[56:59]
    v_mfma_f32_16x16x32_bf16 v[56:59], v[64:67], v[176:179], v[56:59]
    v_mfma_f32_16x16x32_bf16 v[56:59], v[68:71], v[184:187], v[56:59]
    v_mfma_f32_16x16x32_bf16 v[56:59], v[72:75], v[192:195], v[56:59]
    v_mfma_f32_16x16x32_bf16 v[56:59], v[76:79], v[200:203], v[56:59]
    s_cmp_lg_u32 s51, 0
    s_nop 6
    ds_write_b128 v8, v[56:59] offset:1024
    s_waitcnt lgkmcnt(0)
    s_barrier
    ds_read_b128 v[16:19], v9 offset:1024
    ds_read_b128 v[20:23], v9 offset:2048
    ds_read_b128 v[24:27], v9 offset:3072
    s_waitcnt lgkmcnt(1)
    v_pk_add_f32 v[16:17], v[16:17], v[20:21]
    v_pk_add_f32 v[18:19], v[18:19], v[22:23]
    s_waitcnt lgkmcnt(0)
    v_pk_add_f32 v[60:61], v[60:61], v[24:25]
    v_pk_add_f32 v[62:63], v[62:63], v[26:27]
    v_pk_add_f32 v[60:61], v[60:61], v[16:17]
    v_pk_add_f32 v[62:63], v[62:63], v[18:19]
    s_nop 0
    s_waitcnt vmcnt(8)
    v_mfma_f32_16x16x32_bf16 v[60:63], v[40:43], v[148:151], v[60:63]
    s_waitcnt vmcnt(7)
    v_mfma_f32_16x16x32_bf16 v[60:63], v[44:47], v[156:159], v[60:63]
    s_waitcnt vmcnt(6)
    v_mfma_f32_16x16x32_bf16 v[60:63], v[48:51], v[164:167], v[60:63]
    s_waitcnt vmcnt(5)
    v_mfma_f32_16x16x32_bf16 v[60:63], v[52:55], v[172:175], v[60:63]
    s_waitcnt vmcnt(4)
    v_mfma_f32_16x16x32_bf16 v[60:63], v[64:67], v[180:183], v[60:63]
    s_waitcnt vmcnt(3)
    v_mfma_f32_16x16x32_bf16 v[60:63], v[68:71], v[188:191], v[60:63]
    s_waitcnt vmcnt(2)
    v_mfma_f32_16x16x32_bf16 v[60:63], v[72:75], v[196:199], v[60:63]
    s_waitcnt vmcnt(1)
    v_mfma_f32_16x16x32_bf16 v[60:63], v[76:79], v[204:207], v[60:63]
    s_nop 7
    v_perm_b32 v60, v60, v7, s52
    v_perm_b32 v61, v61, v7, s53
    v_perm_b32 v62, v62, v7, s54
    v_perm_b32 v63, v63, v7, s55
    s_cbranch_scc0 Lm_far
    global_store_dwordx4 v1, v[60:63], s[16:17]
    s_endpgm
Lm_far:
    global_store_dwordx4 v1, v[60:63], s[16:17] sc1
    s_endpgm
.section .rodata,"a"
.p2align 6
.amdhsa_kernel standalone__paged_block_table_kv_radixattention__decode_kernel
  .amdhsa_next_free_vgpr 212
  .amdhsa_next_free_sgpr 64
  .amdhsa_accum_offset 212
  .amdhsa_group_segment_fixed_size 0
  .amdhsa_kernarg_size 64
  .amdhsa_user_sgpr_count 2
  .amdhsa_user_sgpr_kernarg_segment_ptr 1
  .amdhsa_system_sgpr_workgroup_id_x 1
.end_amdhsa_kernel
```
